```python
import torch

def _softmax(x, axis=-1):
    return torch.softmax(x, dim=axis)
def _gelu(x):
    return torch.nn.functional.gelu(x, approximate="tanh")
def _silu(x):
    return torch.nn.functional.silu(x)
def _sigmoid(x):
    return torch.sigmoid(x)
def _layernorm(x, axis=-1, eps=1e-5):
    m = x.mean(dim=axis, keepdim=True)
    v = x.var(dim=axis, keepdim=True, unbiased=False)
    return (x - m) / torch.sqrt(v + eps)
def _scatter_add(tgt, idx, src, axis=0):
    return tgt.clone().index_add_(axis, idx, src)
def _segment_sum(src, seg, n):
    out = torch.zeros((n,) + src.shape[1:], dtype=src.dtype)
    return out.index_add_(0, seg, src)
def _pad(x, pw):
    flat = tuple(v for pair in reversed(pw) for v in pair)
    return torch.nn.functional.pad(x, flat)

kernel_name = 'standalone__instancenorm__sampling'

def setup_inputs():

    _w = (lambda a: (lambda t: t.to(torch.bfloat16) if t.is_floating_point() else t)(torch.as_tensor(a)))
    B, C, H, W = 64, 512, 32, 32
    return {
        "x": _w(abs((lambda *s: torch.randn(*s, dtype=torch.bfloat16) * 0.05)(B, C, H, W))),
        "g": _w((lambda *s: torch.randn(*s, dtype=torch.bfloat16) * 0.05)(C) + 1.0),
        "b": _w((lambda *s: torch.randn(*s, dtype=torch.bfloat16) * 0.4)(C)),
    }

def reference(x, g, b):
    mu = x.mean(axis=(-2, -1), keepdims=True)
    var = ((x - mu) ** 2).mean(axis=(-2, -1), keepdims=True)
    xhat = (x - mu) / torch.sqrt(var + 1e-5)
    return xhat * g.reshape(1, -1, 1, 1) + b.reshape(1, -1, 1, 1)
```

```asm
; @launch grid=(256,1,1) block=(576,1,1) lds=2176
.amdgcn_target "amdgcn-amd-amdhsa--gfx950"
.text
.globl standalone__instancenorm__sampling_kernel
.p2align 8
.type standalone__instancenorm__sampling_kernel,@function
standalone__instancenorm__sampling_kernel:
    s_load_dwordx8 s[4:11], s[0:1], 0
    s_load_dwordx4 s[44:47], s[0:1], 32
    v_readfirstlane_b32 s12, v0
    s_cmpk_ge_u32 s2, 256
    s_cbranch_scc1 L_done
    s_lshr_b32 s12, s12, 6
    s_cbranch_scc1 L_both
    s_getpc_b64 s[36:37]
L_pc:
    v_lshlrev_b32 v6, 7, v0
    v_min_u32 v6, L_done-L_pc, v6
    global_load_dword v6, v6, s[36:37]
L_both:
    s_and_b32 s23, s2, 1
    s_mulk_i32 s23, 0x808
    s_and_b32 s3, s2, 2
    s_lshl4_add_u32 s23, s3, s23
    s_and_b32 s3, s2, 24
    s_lshl_b32 s3, s3, 6
    s_or_b32 s23, s23, s3
    s_and_b32 s3, s2, 32
    s_lshl3_add_u32 s23, s3, s23
    s_andn2_b32 s3, s2, 63
    s_or_b32 s23, s23, s3
    s_lshr_b32 s13, s2, 5
    s_bitcmp1_b32 0xa5, s13
    s_cselect_b64 vcc, -1, 0
    s_sub_u32 s24, s12, 1
    s_cbranch_scc0 L_data
    s_mul_i32 s3, s2, 45
    s_bfe_u32 s3, s3, 0x60004
    s_and_b32 s24, s2, 8
    s_xor_b32 s32, s23, s24
    s_lshl3_add_u32 s32, s32, s3
    s_lshl_b32 s32, s32, 7
    v_lshlrev_b32 v8, 4, v0
    s_cbranch_vccz L_timer
    s_bitset1_b32 s32, 23
    s_xor_b32 s33, s32, 0x2000
    s_waitcnt lgkmcnt(0)
    s_load_dword s34, s[4:5], s32 glc
    s_load_dword s35, s[4:5], s33 glc
    s_branch L_probe
L_timer:
    v_and_b32 v10, 1, v0
    v_lshl_add_u32 v10, v10, 13, s32
    s_waitcnt lgkmcnt(0)
    global_load_dword v10, v10, s[4:5] nt
    global_load_ubyte v18, v0, s[44:45]
    global_load_dwordx4 v[20:23], v8, s[6:7]
    global_load_dwordx4 v[24:27], v8, s[8:9]
    s_branch L_timer2
L_data:
    v_and_b32 v0, 63, v0
    v_lshlrev_b32 v0, 4, v0
    s_and_b32 s19, s24, 5
    s_and_b32 s3, s24, 2
    s_lshl2_add_u32 s19, s19, s3
    s_xor_b32 s19, s19, s23
    s_waitcnt lgkmcnt(0)
    s_lshl_b32 s3, s3, 1
    s_xor_b32 s3, s3, s2
    s_and_b32 s3, s3, 4
    s_lshl_b32 s3, s3, 1
    s_xor_b32 s3, s3, s19
    v_lshl_or_b32 v44, s3, 10, v0
    s_cbranch_vccz L_go
    s_barrier
L_go:
    global_load_dwordx4 v[8:11], v44, s[4:5] nt
    global_load_dwordx4 v[12:15], v44, s[4:5] offset:1024 nt
    s_branch L_data2
L_timer2:
    s_getreg_b32 s3, hwreg(HW_REG_XCC_ID, 0, 3)
    s_lshr_b32 s25, s3, 2
    s_sub_u32 s3, s3, s2
    s_and_b32 s3, s3, 7
    s_lshr_b32 s16, 0xf0f0, s3
    s_and_b32 s16, s16, 15
    s_or_b32 s16, s16, 16
    v_mov_b32 v1, 0
    v_mov_b32 v12, 16
    v_mov_b32 v13, 24
    v_mov_b32 v14, 2
    s_waitcnt vmcnt(2)
    s_branch L_read
L_probe:
    s_waitcnt lgkmcnt(1)
    s_getreg_b32 s3, hwreg(HW_REG_XCC_ID, 0, 3)
    s_lshr_b32 s25, s3, 2
    s_sub_u32 s3, s3, s2
    s_and_b32 s3, s3, 7
    s_lshr_b32 s16, 0xf0f0, s3
    s_and_b32 s16, s16, 15
    s_or_b32 s16, s16, 16
    v_mov_b32 v1, 0
    v_mov_b32 v12, 16
    v_mov_b32 v13, 24
    v_mov_b32 v14, 2
    s_lshr_b32 s24, s24, 3
    s_xor_b32 s3, s24, s25
    s_bfe_u32 s23, s2, 0x30004
    s_lshl3_add_u32 s3, s3, s23
    v_lshl_add_u32 v16, v0, 6, s3
    v_mov_b32 v17, 1
    s_mov_b64 exec, 3
    s_getreg_b32 s3, hwreg(HW_REG_IB_STS, 8, 1)
    s_cmp_eq_u32 s3, 0
    s_cbranch_scc1 L_novote
    global_store_byte v16, v17, s[44:45]
L_novote:
    s_mov_b64 exec, -1
    global_load_dwordx4 v[20:23], v8, s[6:7]
    global_load_dwordx4 v[24:27], v8, s[8:9]
    s_barrier
    s_waitcnt lgkmcnt(0)
L_read:
    s_load_dwordx4 s[48:51], s[44:45], 0
    ds_write2_b32 v1, v12, v13 offset1:4
    ds_write2_b32 v1, v14, v1 offset0:3 offset1:7
    s_waitcnt lgkmcnt(0)
    s_bcnt1_i32_b64 s29, s[48:49]
    s_bcnt1_i32_b64 s30, s[50:51]
    s_absdiff_i32 s3, s30, s29
    s_cmp_ge_u32 s3, 2
    s_cbranch_scc1 L_decided
    s_load_dwordx4 s[48:51], s[44:45], 64
    s_waitcnt lgkmcnt(0)
    s_bcnt1_i32_b64 s29, s[48:49]
    s_bcnt1_i32_b64 s30, s[50:51]
    s_absdiff_i32 s3, s30, s29
    s_cmp_ge_u32 s3, 2
    s_cbranch_scc0 L_late
L_decided:
    s_cmp_gt_u32 s30, s29
    s_addc_u32 s23, s25, 0
    s_and_b32 s23, s23, 1
    s_lshl_b32 s3, s23, 13
    v_mov_b32 v13, s3
    ds_write_b32 v1, v13 offset:4
    s_waitcnt vmcnt(1)
    ds_write_b128 v8, v[20:23] offset:128
    s_waitcnt vmcnt(0)
    ds_write_b128 v8, v[24:27] offset:1152
    s_waitcnt lgkmcnt(0)
    s_barrier
    s_branch L_check
L_data2:
    s_cbranch_vccnz L_nopp
    v_add_u32 v7, v44, v0
    v_xor_b32 v7, 0x20000, v7
    global_load_dword v7, v7, s[4:5] nt
L_nopp:
    s_mov_b64 s[40:41], s[10:11]
    s_and_b32 s29, s24, 3
    s_lshl_b32 s27, s29, 3
    s_xor_b32 s27, s27, s2
    s_and_b32 s27, s27, 63
    s_lshl_b32 s27, s27, 8
    s_lshl_b32 s29, s29, 19
    s_mov_b32 s30, 0
    s_cmp_ge_u32 s24, 4
    s_cselect_b32 s28, 1, 0
    v_mov_b32 v1, 0
    v_mov_b32 v2, 1
    s_brev_b32 s6, 32
    s_mov_b32 s7, 0x20000
    s_mov_b32 s42, s6
    s_mov_b32 s43, s7
    s_mov_b32 s18, 0xffff0000
    s_mov_b32 s12, s24
    s_add_u32 s25, s12, 8
    s_lshl_b32 s23, s23, 10
    s_bitset1_b32 s19, 12
    v_lshl_or_b32 v45, s19, 10, v0
    v_mov_b32 v46, 0
    v_mov_b32 v47, 0
    v_mov_b32 v48, 0
    v_mov_b32 v49, 0
    v_mov_b32 v52, 0xba80ba80
    v_mov_b32 v53, v52
    v_mov_b32 v54, v52
    v_mov_b32 v55, v52
    s_barrier
    ds_read_b32 v6, v1 offset:4
    v_bfe_u32 v5, v44, 10, 10
    ds_read_u16_d16_hi v46, v5 offset:128
    ds_read_u16_d16_hi v48, v5 offset:1152
    s_mov_b64 exec, 1
    ds_add_rtn_u32 v3, v1, v2
    s_mov_b64 exec, -1
    s_waitcnt lgkmcnt(3)
    v_xor_b32 v45, v45, v6
    buffer_load_dwordx4 v[16:19], v45, s[4:7], 0 offen nt
    buffer_load_dwordx4 v[20:23], v45, s[4:7], 0 offen offset:1024 nt
    v_bfe_u32 v5, v45, 10, 10
    ds_read_u16_d16_hi v47, v5 offset:128
    ds_read_u16_d16_hi v49, v5 offset:1152
    v_readfirstlane_b32 s3, v6
    s_xor_b32 s23, s23, s3
L_enter:
    s_andn2_b32 s26, s23, 0x30000
    s_xor_b32 s26, s26, s29
    s_waitcnt vmcnt(3) lgkmcnt(0)
    s_cbranch_vccz L_loop
    s_waitcnt vmcnt(2)
L_loop:
    s_cmpk_ge_u32 s24, 164
    s_cbranch_scc1 L_fin
    s_waitcnt vmcnt(4)
    v_mfma_f32_16x16x32_bf16 v[40:43], v[52:55], v[8:11], 0
    v_mfma_f32_16x16x32_bf16 v[40:43], v[52:55], v[12:15], v[40:43]
    v_lshlrev_b32 v24, 16, v8
    v_and_b32 v25, s18, v8
    v_lshlrev_b32 v26, 16, v9
    v_and_b32 v27, s18, v9
    v_lshlrev_b32 v28, 16, v10
    v_and_b32 v29, s18, v10
    v_lshlrev_b32 v30, 16, v11
    v_and_b32 v31, s18, v11
    v_lshlrev_b32 v32, 16, v12
    v_and_b32 v33, s18, v12
    v_add_f32_dpp v40, v40, v40 quad_perm:[1,0,3,2] row_mask:0xf bank_mask:0xf
    v_lshlrev_b32 v34, 16, v13
    v_and_b32 v35, s18, v13
    v_add_f32_dpp v40, v40, v40 quad_perm:[2,3,0,1] row_mask:0xf bank_mask:0xf
    v_lshlrev_b32 v36, 16, v14
    v_and_b32 v37, s18, v14
    v_add_f32_dpp v40, v40, v40 row_half_mirror row_mask:0xf bank_mask:0xf
    v_lshlrev_b32 v38, 16, v15
    v_and_b32 v39, s18, v15
    v_add_f32_dpp v40, v40, v40 row_mirror row_mask:0xf bank_mask:0xf
    v_readfirstlane_b32 s21, v48
    v_pk_add_f32 v[24:25], v[24:25], v[40:41] op_sel_hi:[1,0]
    v_pk_add_f32 v[26:27], v[26:27], v[40:41] op_sel_hi:[1,0]
    v_pk_add_f32 v[28:29], v[28:29], v[40:41] op_sel_hi:[1,0]
    v_pk_add_f32 v[30:31], v[30:31], v[40:41] op_sel_hi:[1,0]
    v_pk_add_f32 v[32:33], v[32:33], v[40:41] op_sel_hi:[1,0]
    v_pk_add_f32 v[34:35], v[34:35], v[40:41] op_sel_hi:[1,0]
    v_pk_add_f32 v[36:37], v[36:37], v[40:41] op_sel_hi:[1,0]
    v_pk_add_f32 v[38:39], v[38:39], v[40:41] op_sel_hi:[1,0]
    v_pk_mul_f32 v[40:41], v[24:25], v[24:25]
    v_pk_mul_f32 v[42:43], v[26:27], v[26:27]
    v_pk_fma_f32 v[40:41], v[28:29], v[28:29], v[40:41]
    v_pk_fma_f32 v[42:43], v[30:31], v[30:31], v[42:43]
    v_pk_fma_f32 v[40:41], v[32:33], v[32:33], v[40:41]
    v_pk_fma_f32 v[42:43], v[34:35], v[34:35], v[42:43]
    v_pk_fma_f32 v[40:41], v[36:37], v[36:37], v[40:41]
    v_pk_fma_f32 v[42:43], v[38:39], v[38:39], v[42:43]
    v_pk_add_f32 v[40:41], v[40:41], v[42:43]
    v_add_f32 v40, v40, v41
    v_mov_b32 v42, 0x3727c5ac
    s_nop 0
    v_add_f32_dpp v40, v40, v40 quad_perm:[1,0,3,2] row_mask:0xf bank_mask:0xf
    s_nop 1
    v_add_f32_dpp v40, v40, v40 quad_perm:[2,3,0,1] row_mask:0xf bank_mask:0xf
    s_nop 1
    v_add_f32_dpp v40, v40, v40 row_half_mirror row_mask:0xf bank_mask:0xf
    s_nop 1
    v_add_f32_dpp v40, v40, v40 row_mirror row_mask:0xf bank_mask:0xf
    s_nop 1
    v_add_f32_dpp v40, v40, v40 row_bcast:15 row_mask:0xa bank_mask:0xf
    s_nop 1
    v_add_f32_dpp v40, v40, v40 row_bcast:31 row_mask:0xc bank_mask:0xf
    v_fmac_f32 v42, 0x3a800000, v40
    v_rsq_f32 v42, v42
    s_cmpk_ge_u32 s24, 140
    v_mul_f32 v42, v46, v42
    s_nop 0
    v_readlane_b32 s20, v42, 63
    s_nop 1
    v_pk_fma_f32 v[24:25], v[24:25], s[20:21], s[20:21] op_sel:[0,0,1] op_sel_hi:[1,0,1]
    v_pk_fma_f32 v[26:27], v[26:27], s[20:21], s[20:21] op_sel:[0,0,1] op_sel_hi:[1,0,1]
    v_pk_fma_f32 v[28:29], v[28:29], s[20:21], s[20:21] op_sel:[0,0,1] op_sel_hi:[1,0,1]
    v_pk_fma_f32 v[30:31], v[30:31], s[20:21], s[20:21] op_sel:[0,0,1] op_sel_hi:[1,0,1]
    v_cvt_pk_bf16_f32 v8, v24, v25
    v_cvt_pk_bf16_f32 v9, v26, v27
    v_cvt_pk_bf16_f32 v10, v28, v29
    v_cvt_pk_bf16_f32 v11, v30, v31
    s_cbranch_scc0 L_wt00
    buffer_store_dwordx4 v[8:11], v44, s[40:43], 0 offen
    s_branch L_st00
L_wt00:
    buffer_store_dwordx4 v[8:11], v44, s[40:43], 0 offen sc1
L_st00:
    v_pk_fma_f32 v[32:33], v[32:33], s[20:21], s[20:21] op_sel:[0,0,1] op_sel_hi:[1,0,1]
    v_pk_fma_f32 v[34:35], v[34:35], s[20:21], s[20:21] op_sel:[0,0,1] op_sel_hi:[1,0,1]
    v_pk_fma_f32 v[36:37], v[36:37], s[20:21], s[20:21] op_sel:[0,0,1] op_sel_hi:[1,0,1]
    v_pk_fma_f32 v[38:39], v[38:39], s[20:21], s[20:21] op_sel:[0,0,1] op_sel_hi:[1,0,1]
    v_cvt_pk_bf16_f32 v12, v32, v33
    v_cvt_pk_bf16_f32 v13, v34, v35
    v_cvt_pk_bf16_f32 v14, v36, v37
    v_cvt_pk_bf16_f32 v15, v38, v39
    s_cbranch_scc0 L_wt01
    buffer_store_dwordx4 v[12:15], v44, s[40:43], 0 offen offset:1024
    s_branch L_st01
L_wt01:
    buffer_store_dwordx4 v[12:15], v44, s[40:43], 0 offen offset:1024 sc1
L_st01:
    s_waitcnt lgkmcnt(0)
    v_readfirstlane_b32 s24, v3
    s_add_u32 s24, s24, s30
    s_cmpk_ge_u32 s24, 164
    s_cbranch_scc1 L_none0
    s_cmpk_ge_u32 s24, 108
    s_cbranch_scc1 L_pool0
    s_mov_b64 exec, 1
    ds_add_rtn_u32 v3, v1, v2
    s_mov_b64 exec, -1
L_drawn0:
    s_sub_u32 s13, s24, 116
    s_and_b32 s22, s13, 3
    s_lshl_b32 s22, s22, 16
    s_xor_b32 s22, s22, s26
    s_lshr_b32 s13, s13, 2
    s_addk_i32 s13, 116
    s_cmpk_ge_u32 s24, 116
    s_cselect_b32 s13, s13, s24
    s_cselect_b32 s22, s22, s23
    s_and_b32 s19, s13, 5
    s_and_b32 s3, s13, 2
    s_lshl2_add_u32 s19, s19, s3
    s_lshr_b32 s3, s13, 3
    s_lshl_b32 s3, s3, 12
    s_or_b32 s19, s19, s3
    s_lshl_b32 s19, s19, 10
    s_xor_b32 s19, s19, s22
    v_or_b32 v44, s19, v0
    buffer_load_dwordx4 v[8:11], v44, s[4:7], 0 offen nt
    buffer_load_dwordx4 v[12:15], v44, s[4:7], 0 offen offset:1024 nt
    v_bfe_u32 v5, v44, 10, 10
    ds_read_u16_d16_hi v46, v5 offset:128
    ds_read_u16_d16_hi v48, v5 offset:1152
L_mid:
    s_cmpk_ge_u32 s25, 164
    s_cbranch_scc1 L_fin
    s_waitcnt vmcnt(4)
    v_mfma_f32_16x16x32_bf16 v[40:43], v[52:55], v[16:19], 0
    v_mfma_f32_16x16x32_bf16 v[40:43], v[52:55], v[20:23], v[40:43]
    v_lshlrev_b32 v24, 16, v16
    v_and_b32 v25, s18, v16
    v_lshlrev_b32 v26, 16, v17
    v_and_b32 v27, s18, v17
    v_lshlrev_b32 v28, 16, v18
    v_and_b32 v29, s18, v18
    v_lshlrev_b32 v30, 16, v19
    v_and_b32 v31, s18, v19
    v_lshlrev_b32 v32, 16, v20
    v_and_b32 v33, s18, v20
    v_add_f32_dpp v40, v40, v40 quad_perm:[1,0,3,2] row_mask:0xf bank_mask:0xf
    v_lshlrev_b32 v34, 16, v21
    v_and_b32 v35, s18, v21
    v_add_f32_dpp v40, v40, v40 quad_perm:[2,3,0,1] row_mask:0xf bank_mask:0xf
    v_lshlrev_b32 v36, 16, v22
    v_and_b32 v37, s18, v22
    v_add_f32_dpp v40, v40, v40 row_half_mirror row_mask:0xf bank_mask:0xf
    v_lshlrev_b32 v38, 16, v23
    v_and_b32 v39, s18, v23
    v_add_f32_dpp v40, v40, v40 row_mirror row_mask:0xf bank_mask:0xf
    v_readfirstlane_b32 s21, v49
    v_pk_add_f32 v[24:25], v[24:25], v[40:41] op_sel_hi:[1,0]
    v_pk_add_f32 v[26:27], v[26:27], v[40:41] op_sel_hi:[1,0]
    v_pk_add_f32 v[28:29], v[28:29], v[40:41] op_sel_hi:[1,0]
    v_pk_add_f32 v[30:31], v[30:31], v[40:41] op_sel_hi:[1,0]
    v_pk_add_f32 v[32:33], v[32:33], v[40:41] op_sel_hi:[1,0]
    v_pk_add_f32 v[34:35], v[34:35], v[40:41] op_sel_hi:[1,0]
    v_pk_add_f32 v[36:37], v[36:37], v[40:41] op_sel_hi:[1,0]
    v_pk_add_f32 v[38:39], v[38:39], v[40:41] op_sel_hi:[1,0]
    v_pk_mul_f32 v[40:41], v[24:25], v[24:25]
    v_pk_mul_f32 v[42:43], v[26:27], v[26:27]
    v_pk_fma_f32 v[40:41], v[28:29], v[28:29], v[40:41]
    v_pk_fma_f32 v[42:43], v[30:31], v[30:31], v[42:43]
    v_pk_fma_f32 v[40:41], v[32:33], v[32:33], v[40:41]
    v_pk_fma_f32 v[42:43], v[34:35], v[34:35], v[42:43]
    v_pk_fma_f32 v[40:41], v[36:37], v[36:37], v[40:41]
    v_pk_fma_f32 v[42:43], v[38:39], v[38:39], v[42:43]
    v_pk_add_f32 v[40:41], v[40:41], v[42:43]
    v_add_f32 v40, v40, v41
    v_mov_b32 v42, 0x3727c5ac
    s_nop 0
    v_add_f32_dpp v40, v40, v40 quad_perm:[1,0,3,2] row_mask:0xf bank_mask:0xf
    s_nop 1
    v_add_f32_dpp v40, v40, v40 quad_perm:[2,3,0,1] row_mask:0xf bank_mask:0xf
    s_nop 1
    v_add_f32_dpp v40, v40, v40 row_half_mirror row_mask:0xf bank_mask:0xf
    s_nop 1
    v_add_f32_dpp v40, v40, v40 row_mirror row_mask:0xf bank_mask:0xf
    s_nop 1
    v_add_f32_dpp v40, v40, v40 row_bcast:15 row_mask:0xa bank_mask:0xf
    s_nop 1
    v_add_f32_dpp v40, v40, v40 row_bcast:31 row_mask:0xc bank_mask:0xf
    v_fmac_f32 v42, 0x3a800000, v40
    v_rsq_f32 v42, v42
    s_cmpk_ge_u32 s25, 140
    v_mul_f32 v42, v47, v42
    s_nop 0
    v_readlane_b32 s20, v42, 63
    s_nop 1
    v_pk_fma_f32 v[24:25], v[24:25], s[20:21], s[20:21] op_sel:[0,0,1] op_sel_hi:[1,0,1]
    v_pk_fma_f32 v[26:27], v[26:27], s[20:21], s[20:21] op_sel:[0,0,1] op_sel_hi:[1,0,1]
    v_pk_fma_f32 v[28:29], v[28:29], s[20:21], s[20:21] op_sel:[0,0,1] op_sel_hi:[1,0,1]
    v_pk_fma_f32 v[30:31], v[30:31], s[20:21], s[20:21] op_sel:[0,0,1] op_sel_hi:[1,0,1]
    v_cvt_pk_bf16_f32 v16, v24, v25
    v_cvt_pk_bf16_f32 v17, v26, v27
    v_cvt_pk_bf16_f32 v18, v28, v29
    v_cvt_pk_bf16_f32 v19, v30, v31
    s_cbranch_scc0 L_wt10
    buffer_store_dwordx4 v[16:19], v45, s[40:43], 0 offen
    s_branch L_st10
L_wt10:
    buffer_store_dwordx4 v[16:19], v45, s[40:43], 0 offen sc1
L_st10:
    v_pk_fma_f32 v[32:33], v[32:33], s[20:21], s[20:21] op_sel:[0,0,1] op_sel_hi:[1,0,1]
    v_pk_fma_f32 v[34:35], v[34:35], s[20:21], s[20:21] op_sel:[0,0,1] op_sel_hi:[1,0,1]
    v_pk_fma_f32 v[36:37], v[36:37], s[20:21], s[20:21] op_sel:[0,0,1] op_sel_hi:[1,0,1]
    v_pk_fma_f32 v[38:39], v[38:39], s[20:21], s[20:21] op_sel:[0,0,1] op_sel_hi:[1,0,1]
    v_cvt_pk_bf16_f32 v20, v32, v33
    v_cvt_pk_bf16_f32 v21, v34, v35
    v_cvt_pk_bf16_f32 v22, v36, v37
    v_cvt_pk_bf16_f32 v23, v38, v39
    s_cbranch_scc0 L_wt11
    buffer_store_dwordx4 v[20:23], v45, s[40:43], 0 offen offset:1024
    s_branch L_st11
L_wt11:
    buffer_store_dwordx4 v[20:23], v45, s[40:43], 0 offen offset:1024 sc1
L_st11:
    s_waitcnt lgkmcnt(0)
    v_readfirstlane_b32 s25, v3
    s_add_u32 s25, s25, s30
    s_cmpk_ge_u32 s25, 164
    s_cbranch_scc1 L_none1
    s_cmpk_ge_u32 s25, 108
    s_cbranch_scc1 L_pool1
    s_mov_b64 exec, 1
    ds_add_rtn_u32 v3, v1, v2
    s_mov_b64 exec, -1
L_drawn1:
    s_sub_u32 s13, s25, 116
    s_and_b32 s22, s13, 3
    s_lshl_b32 s22, s22, 16
    s_xor_b32 s22, s22, s26
    s_lshr_b32 s13, s13, 2
    s_addk_i32 s13, 116
    s_cmpk_ge_u32 s25, 116
    s_cselect_b32 s13, s13, s25
    s_cselect_b32 s22, s22, s23
    s_and_b32 s19, s13, 5
    s_and_b32 s3, s13, 2
    s_lshl2_add_u32 s19, s19, s3
    s_lshr_b32 s3, s13, 3
    s_lshl_b32 s3, s3, 12
    s_or_b32 s19, s19, s3
    s_lshl_b32 s19, s19, 10
    s_xor_b32 s19, s19, s22
    v_or_b32 v45, s19, v0
    buffer_load_dwordx4 v[16:19], v45, s[4:7], 0 offen nt
    buffer_load_dwordx4 v[20:23], v45, s[4:7], 0 offen offset:1024 nt
    v_bfe_u32 v5, v45, 10, 10
    ds_read_u16_d16_hi v47, v5 offset:128
    ds_read_u16_d16_hi v49, v5 offset:1152
    s_branch L_loop
L_pool0:
    s_cmpk_ge_u32 s24, 116
    s_cbranch_scc1 L_pdraw0
L_pwait0:
    ds_read_b32 v6, v1 offset:12
    s_waitcnt lgkmcnt(0)
    v_readfirstlane_b32 s3, v6
    s_cmp_eq_u32 s3, 2
    s_cbranch_scc1 L_pwait0
    s_or_b32 s3, s3, s28
    v_mov_b32 v3, 164
    s_cbranch_scc1 L_drawn0
    v_mov_b32 v3, 116
L_pdraw0:
    s_mov_b32 s30, 1
    s_atomic_add s30, s[46:47], s27 glc
    s_branch L_drawn0
L_pool1:
    s_cmpk_ge_u32 s25, 116
    s_cbranch_scc1 L_pdraw1
L_pwait1:
    ds_read_b32 v6, v1 offset:12
    s_waitcnt lgkmcnt(0)
    v_readfirstlane_b32 s3, v6
    s_cmp_eq_u32 s3, 2
    s_cbranch_scc1 L_pwait1
    s_or_b32 s3, s3, s28
    v_mov_b32 v3, 164
    s_cbranch_scc1 L_drawn1
    v_mov_b32 v3, 116
L_pdraw1:
    s_mov_b32 s30, 1
    s_atomic_add s30, s[46:47], s27 glc
    s_branch L_drawn1
L_none0:
    s_waitcnt vmcnt(2)
    s_branch L_mid
L_none1:
    s_waitcnt vmcnt(2)
    s_branch L_loop
L_fin:
    ds_read_b32 v6, v1 offset:12
    s_waitcnt lgkmcnt(0)
    v_readfirstlane_b32 s3, v6
    s_cmp_lg_u32 s3, 0
    s_cbranch_scc1 L_more
    s_endpgm
L_more:
    s_xor_b32 s23, s23, 0x2000
    s_mov_b32 s22, s23
    v_mov_b32 v1, 16
    s_mov_b64 vcc, -1
    s_add_u32 s24, s12, 8
    s_add_u32 s25, s12, 16
    s_waitcnt vmcnt(0)
    s_mov_b64 exec, 1
    ds_add_rtn_u32 v3, v1, v2
    s_mov_b64 exec, -1
    s_mov_b32 s13, s24
    s_and_b32 s19, s13, 5
    s_and_b32 s3, s13, 2
    s_lshl2_add_u32 s19, s19, s3
    s_lshr_b32 s3, s13, 3
    s_lshl_b32 s3, s3, 12
    s_or_b32 s19, s19, s3
    s_lshl_b32 s19, s19, 10
    s_xor_b32 s19, s19, s22
    v_or_b32 v44, s19, v0
    buffer_load_dwordx4 v[8:11], v44, s[4:7], 0 offen nt
    buffer_load_dwordx4 v[12:15], v44, s[4:7], 0 offen offset:1024 nt
    v_bfe_u32 v5, v44, 10, 10
    ds_read_u16_d16_hi v46, v5 offset:128
    ds_read_u16_d16_hi v48, v5 offset:1152
    s_mov_b32 s13, s25
    s_and_b32 s19, s13, 5
    s_and_b32 s3, s13, 2
    s_lshl2_add_u32 s19, s19, s3
    s_lshr_b32 s3, s13, 3
    s_lshl_b32 s3, s3, 12
    s_or_b32 s19, s19, s3
    s_lshl_b32 s19, s19, 10
    s_xor_b32 s19, s19, s22
    v_or_b32 v45, s19, v0
    buffer_load_dwordx4 v[16:19], v45, s[4:7], 0 offen nt
    buffer_load_dwordx4 v[20:23], v45, s[4:7], 0 offen offset:1024 nt
    v_bfe_u32 v5, v45, 10, 10
    ds_read_u16_d16_hi v47, v5 offset:128
    ds_read_u16_d16_hi v49, v5 offset:1152
    s_branch L_enter
L_late:
    global_load_dword v28, v1, s[44:45] nt
    s_waitcnt vmcnt(0)
    global_load_dwordx4 v[28:31], v1, s[44:45] nt
    s_waitcnt vmcnt(0)
    v_bcnt_u32_b32 v28, v28, 0
    v_bcnt_u32_b32 v30, v30, 0
    v_bcnt_u32_b32 v28, v29, v28
    v_bcnt_u32_b32 v30, v31, v30
    v_readfirstlane_b32 s29, v28
    v_readfirstlane_b32 s30, v30
    s_branch L_decided
L_check:
    s_xor_b32 s13, s23, s25
    s_mul_i32 s13, s13, 15
    s_xor_b32 s16, s16, s13
    s_cmp_eq_u32 s2, 0
    s_cbranch_scc1 L_propose
L_wait:
    ds_read_b32 v11, v1
    s_waitcnt lgkmcnt(0)
    v_readfirstlane_b32 s3, v11
    s_cmpk_lt_u32 s3, 72
    s_cbranch_scc1 L_wait
    s_load_dword s3, s[44:45], 0x80
    s_waitcnt lgkmcnt(0)
    s_cmp_lg_u32 s3, 0
    s_cbranch_scc1 L_official
L_propose:
    v_lshlrev_b32 v12, 8, v0
    v_mov_b32 v13, 0
    global_store_dword v12, v13, s[46:47] sc0 sc1
    s_mov_b64 exec, 1
    s_waitcnt vmcnt(0)
    v_mov_b32 v12, s16
    global_atomic_cmpswap v12, v1, v[12:13], s[44:45] offset:128 sc0 sc1
    s_waitcnt vmcnt(0)
    v_readfirstlane_b32 s3, v12
    s_cmp_eq_u32 s3, 0
    s_cselect_b32 s3, s16, s3
L_official:
    s_and_b32 s13, s2, 3
    s_lshr_b32 s3, s3, s13
    s_lshr_b32 s13, s2, 2
    s_xor_b32 s3, s3, s13
    s_xor_b32 s16, s3, s23
    s_and_b32 s16, s16, 1
    s_mov_b64 exec, 1
    v_mov_b32 v15, s16
    ds_write_b32 v1, v15 offset:12
    v_lshlrev_b32 v15, 8, v15
    ds_max_u32 v1, v15
    s_waitcnt lgkmcnt(0)
L_done:
    s_endpgm
.section .rodata,"a"
.p2align 6
.amdhsa_kernel standalone__instancenorm__sampling_kernel
  .amdhsa_next_free_vgpr 56
  .amdhsa_next_free_sgpr 52
  .amdhsa_accum_offset 56
  .amdhsa_group_segment_fixed_size 0
  .amdhsa_kernarg_size 48
  .amdhsa_user_sgpr_count 2
  .amdhsa_user_sgpr_kernarg_segment_ptr 1
  .amdhsa_system_sgpr_workgroup_id_x 1
  .amdhsa_float_denorm_mode_32 3
.end_amdhsa_kernel
```
